```python
import torch

def _softmax(x, axis=-1):
    return torch.softmax(x, dim=axis)
def _gelu(x):
    return torch.nn.functional.gelu(x, approximate="tanh")
def _silu(x):
    return torch.nn.functional.silu(x)
def _sigmoid(x):
    return torch.sigmoid(x)
def _layernorm(x, axis=-1, eps=1e-5):
    m = x.mean(dim=axis, keepdim=True)
    v = x.var(dim=axis, keepdim=True, unbiased=False)
    return (x - m) / torch.sqrt(v + eps)
def _scatter_add(tgt, idx, src, axis=0):
    return tgt.clone().index_add_(axis, idx, src)
def _segment_sum(src, seg, n):
    out = torch.zeros((n,) + src.shape[1:], dtype=src.dtype)
    return out.index_add_(0, seg, src)
def _pad(x, pw):
    flat = tuple(v for pair in reversed(pw) for v in pair)
    return torch.nn.functional.pad(x, flat)

kernel_name = 'standalone__rezero__prompt'

def setup_inputs():

    _w = (lambda a: (lambda t: t.to(torch.bfloat16) if t.is_floating_point() else t)(torch.as_tensor(a)))
    B, S, D = 4, 2048, 448
    return {
        "x": _w((lambda *s: torch.randn(*s, dtype=torch.bfloat16) * 0.05)(B, S, D)),
        "fx": _w((lambda *s: torch.randn(*s, dtype=torch.bfloat16) * 0.4)(B, S, D)),
        "alpha": _w((lambda *s: torch.randn(*s, dtype=torch.bfloat16) * 0.4)(1) * 0.1),
    }

def reference(x, fx, alpha):
    return x + alpha * fx
```

```asm
; @launch grid=(256,1,1) block=(896,1,1) lds=0
.amdgcn_target "amdgcn-amd-amdhsa--gfx950"
.text
.globl standalone__rezero__prompt_kernel
.p2align 8
.type standalone__rezero__prompt_kernel,@function
standalone__rezero__prompt_kernel:
    s_load_dwordx8 s[4:11], s[0:1], 0
    s_cmp_ge_u32 s2, 256
    s_cbranch_scc1 L_END
    s_mul_i32 s3, s2, 28672
    v_lshrrev_b32 v1, 6, v0
    v_and_b32 v0, 63, v0
    v_lshlrev_b32 v0, 4, v0
    v_mul_u32_u24 v1, 2048, v1
    v_add3_u32 v0, v0, v1, s3
    s_mov_b32 s15, 0xffff0000
    s_waitcnt lgkmcnt(0)
    s_load_dword s12, s[8:9], 0
    global_load_dwordx4 v[8:11], v0, s[4:5] nt
    global_load_dwordx4 v[12:15], v0, s[6:7] nt
    global_load_dwordx4 v[16:19], v0, s[4:5] offset:1024 nt
    global_load_dwordx4 v[20:23], v0, s[6:7] offset:1024 nt
    s_waitcnt lgkmcnt(0)
    s_lshl_b32 s12, s12, 16
    s_waitcnt vmcnt(2)
    v_lshlrev_b32 v2, 16, v12
    v_and_b32 v3, s15, v12
    v_lshlrev_b32 v4, 16, v8
    v_pk_mul_f32 v[2:3], v[2:3], s[12:13] op_sel_hi:[1,0]
    v_and_b32 v5, s15, v8
    v_cvt_pk_bf16_f32 v12, v2, v3
    v_lshlrev_b32 v2, 16, v12
    v_and_b32 v3, s15, v12
    v_pk_add_f32 v[2:3], v[2:3], v[4:5]
    v_cvt_pk_bf16_f32 v12, v2, v3
    v_lshlrev_b32 v2, 16, v13
    v_and_b32 v3, s15, v13
    v_lshlrev_b32 v4, 16, v9
    v_pk_mul_f32 v[2:3], v[2:3], s[12:13] op_sel_hi:[1,0]
    v_and_b32 v5, s15, v9
    v_cvt_pk_bf16_f32 v13, v2, v3
    v_lshlrev_b32 v2, 16, v13
    v_and_b32 v3, s15, v13
    v_pk_add_f32 v[2:3], v[2:3], v[4:5]
    v_cvt_pk_bf16_f32 v13, v2, v3
    v_lshlrev_b32 v2, 16, v14
    v_and_b32 v3, s15, v14
    v_lshlrev_b32 v4, 16, v10
    v_pk_mul_f32 v[2:3], v[2:3], s[12:13] op_sel_hi:[1,0]
    v_and_b32 v5, s15, v10
    v_cvt_pk_bf16_f32 v14, v2, v3
    v_lshlrev_b32 v2, 16, v14
    v_and_b32 v3, s15, v14
    v_pk_add_f32 v[2:3], v[2:3], v[4:5]
    v_cvt_pk_bf16_f32 v14, v2, v3
    v_lshlrev_b32 v2, 16, v15
    v_and_b32 v3, s15, v15
    v_lshlrev_b32 v4, 16, v11
    v_pk_mul_f32 v[2:3], v[2:3], s[12:13] op_sel_hi:[1,0]
    v_and_b32 v5, s15, v11
    v_cvt_pk_bf16_f32 v15, v2, v3
    v_lshlrev_b32 v2, 16, v15
    v_and_b32 v3, s15, v15
    v_pk_add_f32 v[2:3], v[2:3], v[4:5]
    v_cvt_pk_bf16_f32 v15, v2, v3
    global_store_dwordx4 v0, v[12:15], s[10:11]
    s_waitcnt vmcnt(1)
    v_lshlrev_b32 v2, 16, v20
    v_and_b32 v3, s15, v20
    v_lshlrev_b32 v4, 16, v16
    v_pk_mul_f32 v[2:3], v[2:3], s[12:13] op_sel_hi:[1,0]
    v_and_b32 v5, s15, v16
    v_cvt_pk_bf16_f32 v20, v2, v3
    v_lshlrev_b32 v2, 16, v20
    v_and_b32 v3, s15, v20
    v_pk_add_f32 v[2:3], v[2:3], v[4:5]
    v_cvt_pk_bf16_f32 v20, v2, v3
    v_lshlrev_b32 v2, 16, v21
    v_and_b32 v3, s15, v21
    v_lshlrev_b32 v4, 16, v17
    v_pk_mul_f32 v[2:3], v[2:3], s[12:13] op_sel_hi:[1,0]
    v_and_b32 v5, s15, v17
    v_cvt_pk_bf16_f32 v21, v2, v3
    v_lshlrev_b32 v2, 16, v21
    v_and_b32 v3, s15, v21
    v_pk_add_f32 v[2:3], v[2:3], v[4:5]
    v_cvt_pk_bf16_f32 v21, v2, v3
    v_lshlrev_b32 v2, 16, v22
    v_and_b32 v3, s15, v22
    v_lshlrev_b32 v4, 16, v18
    v_pk_mul_f32 v[2:3], v[2:3], s[12:13] op_sel_hi:[1,0]
    v_and_b32 v5, s15, v18
    v_cvt_pk_bf16_f32 v22, v2, v3
    v_lshlrev_b32 v2, 16, v22
    v_and_b32 v3, s15, v22
    v_pk_add_f32 v[2:3], v[2:3], v[4:5]
    v_cvt_pk_bf16_f32 v22, v2, v3
    v_lshlrev_b32 v2, 16, v23
    v_and_b32 v3, s15, v23
    v_lshlrev_b32 v4, 16, v19
    v_pk_mul_f32 v[2:3], v[2:3], s[12:13] op_sel_hi:[1,0]
    v_and_b32 v5, s15, v19
    v_cvt_pk_bf16_f32 v23, v2, v3
    v_lshlrev_b32 v2, 16, v23
    v_and_b32 v3, s15, v23
    v_pk_add_f32 v[2:3], v[2:3], v[4:5]
    v_cvt_pk_bf16_f32 v23, v2, v3
    global_store_dwordx4 v0, v[20:23], s[10:11] offset:1024
L_END:
    s_endpgm
.section .rodata,"a"
.p2align 6
.amdhsa_kernel standalone__rezero__prompt_kernel
  .amdhsa_next_free_vgpr 24
  .amdhsa_next_free_sgpr 24
  .amdhsa_accum_offset 24
  .amdhsa_group_segment_fixed_size 0
  .amdhsa_kernarg_size 48
  .amdhsa_user_sgpr_count 2
  .amdhsa_user_sgpr_kernarg_segment_ptr 1
  .amdhsa_system_sgpr_workgroup_id_x 1
  .amdhsa_float_denorm_mode_32 3
.end_amdhsa_kernel
```
